```python
import torch

def _softmax(x, axis=-1):
    return torch.softmax(x, dim=axis)
def _gelu(x):
    return torch.nn.functional.gelu(x, approximate="tanh")
def _silu(x):
    return torch.nn.functional.silu(x)
def _sigmoid(x):
    return torch.sigmoid(x)
def _layernorm(x, axis=-1, eps=1e-5):
    m = x.mean(dim=axis, keepdim=True)
    v = x.var(dim=axis, keepdim=True, unbiased=False)
    return (x - m) / torch.sqrt(v + eps)
def _scatter_add(tgt, idx, src, axis=0):
    return tgt.clone().index_add_(axis, idx, src)
def _segment_sum(src, seg, n):
    out = torch.zeros((n,) + src.shape[1:], dtype=src.dtype)
    return out.index_add_(0, seg, src)
def _pad(x, pw):
    flat = tuple(v for pair in reversed(pw) for v in pair)
    return torch.nn.functional.pad(x, flat)

kernel_name = 'standalone__mha_softmax__decode'

def setup_inputs():

    _w = (lambda a: (lambda t: t.to(torch.bfloat16) if t.is_floating_point() else t)(torch.as_tensor(a)))
    B, H, Sq, Sk, D = 8, 32, 1, 4096, 128
    return {
        "q": _w((lambda *s: torch.randn(*s, dtype=torch.bfloat16) * 0.8)(B, H, Sq, D)),
        "k": _w((lambda *s: torch.randn(*s, dtype=torch.bfloat16) * 0.8)(B, H, Sk, D)),
        "v": _w((lambda *s: torch.randn(*s, dtype=torch.bfloat16) * 0.05)(B, H, Sk, D)),
    }

def reference(q, k, v):
    scale = q.shape[-1] ** -0.5
    scores = torch.einsum("bhqd,bhkd->bhqk", q, k) * scale
    p = _softmax(scores, axis=-1)
    return torch.einsum("bhqk,bhkd->bhqd", p, v)
```

```asm
; @launch grid=(256,1,1) block=(64,1,1) lds=19200
.amdgcn_target "amdgcn-amd-amdhsa--gfx950"
.text
.globl standalone__mha_softmax__decode_kernel
.p2align 12
.fill 704, 4, 0xbf810000
.p2align 8
.type standalone__mha_softmax__decode_kernel,@function
standalone__mha_softmax__decode_kernel:
    s_load_dwordx8 s[4:11], s[0:1], 0
    s_load_dwordx4 s[16:19], s[0:1], 32
    s_cmpk_gt_u32 s2, 0xff
    s_cbranch_scc1 L_end
    s_lshr_b32 s3, s2, 3
    s_mov_b64 exec, 0
    s_cmp_eq_u32 s3, 1
    s_cbranch_scc1 L_pad_p
    s_cmp_eq_u32 s3, 2
    s_cbranch_scc1 L_pad_k
    s_cmp_eq_u32 s3, 3
    s_cbranch_scc1 L_pad_k16
    s_cmp_eq_u32 s3, 4
    s_cbranch_scc1 L_pad_t
    s_cmp_eq_u32 s3, 5
    s_cbranch_scc1 L_pad_v
L_warm:
    s_mov_b64 exec, -1
    v_lshlrev_b32 v6, 4, v0
    v_lshlrev_b32 v4, 2, v0
    v_and_b32 v1, 48, v6
    v_and_b32 v4, 0xc0, v4
    v_lshlrev_b32 v5, 6, v0
    v_or_b32 v13, v1, v4
    v_and_b32 v5, 0x300, v5
    v_or_b32 v1, v13, v5
    s_lshr_b32 s3, s2, 2
    s_bcnt1_i32_b32 s25, s3
    s_lshr_b32 s3, s2, 1
    s_xor_b32 s30, s3, s25
    s_and_b32 s30, s30, 1
    s_and_b32 s3, s3, 2
    s_lshl2_add_u32 s3, s30, s3
    s_andn2_b32 s30, s2, 6
    s_or_b32 s30, s30, s3
    s_and_b32 s25, s25, 1
    s_lshl_b32 s23, s25, 13
    s_lshl_b32 s3, s30, 20
    s_lshl_b32 s31, s30, 8
    s_mov_b32 s14, 0x100000
    s_mov_b32 s15, 0x20000
    v_add_u32 v13, s31, v13
    s_xor_b32 s24, s23, 0x8000
    v_mov_b32 v40, 0
    v_mov_b32 v41, 0
    v_mov_b32 v42, 0
    v_mov_b32 v43, 0
    v_mov_b32 v44, 0
    v_mov_b32 v45, 0
    v_mov_b32 v46, 0
    v_mov_b32 v47, 0
    v_mov_b32 v48, 0
    v_mov_b32 v49, 0
    v_mov_b32 v50, 0
    v_mov_b32 v51, 0
    v_mov_b32 v52, 0
    v_mov_b32 v53, 0
    v_mov_b32 v54, 0
    v_mov_b32 v55, 0
    s_waitcnt lgkmcnt(0)
    s_add_u32 s12, s6, s3
    s_addc_u32 s13, s7, 0
    s_load_dword s64, s[4:5], 0
    s_load_dword s65, s[16:17], 128
    s_load_dword s66, s[18:19], 0
    buffer_load_dwordx4 v[56:59], v1, s[12:15], s24 offen offset:0 nt
    buffer_load_dwordx4 v[60:63], v1, s[12:15], s24 offen offset:1024 nt
    buffer_load_dwordx4 v[64:67], v1, s[12:15], s24 offen offset:2048 nt
    buffer_load_dwordx4 v[68:71], v1, s[12:15], s24 offen offset:3072 nt
    global_load_dwordx4 v[36:39], v13, s[4:5]
    s_xor_b32 s24, s23, 0x2000
    buffer_load_dwordx4 v[72:75], v1, s[12:15], s24 offen offset:0 nt
    buffer_load_dwordx4 v[76:79], v1, s[12:15], s24 offen offset:1024 nt
    buffer_load_dwordx4 v[80:83], v1, s[12:15], s24 offen offset:2048 nt
    buffer_load_dwordx4 v[84:87], v1, s[12:15], s24 offen offset:3072 nt
    s_xor_b32 s24, s23, 0xa000
    buffer_load_dwordx4 v[88:91], v1, s[12:15], s24 offen offset:0 nt
    buffer_load_dwordx4 v[92:95], v1, s[12:15], s24 offen offset:1024 nt
    buffer_load_dwordx4 v[96:99], v1, s[12:15], s24 offen offset:2048 nt
    buffer_load_dwordx4 v[100:103], v1, s[12:15], s24 offen offset:3072 nt
    s_xor_b32 s24, s23, 0x3000
    buffer_load_dwordx4 v[104:107], v1, s[12:15], s24 offen offset:0 nt
    buffer_load_dwordx4 v[108:111], v1, s[12:15], s24 offen offset:1024 nt
    buffer_load_dwordx4 v[112:115], v1, s[12:15], s24 offen offset:2048 nt
    buffer_load_dwordx4 v[116:119], v1, s[12:15], s24 offen offset:3072 nt
    s_xor_b32 s24, s23, 0xb000
    buffer_load_dwordx4 v[120:123], v1, s[12:15], s24 offen offset:0 nt
    buffer_load_dwordx4 v[124:127], v1, s[12:15], s24 offen offset:1024 nt
    buffer_load_dwordx4 v[128:131], v1, s[12:15], s24 offen offset:2048 nt
    buffer_load_dwordx4 v[132:135], v1, s[12:15], s24 offen offset:3072 nt
    s_add_u32 s20, s8, s3
    s_addc_u32 s21, s9, 0
    s_load_dword s67, s[20:21], 0
L_pad_p:
    s_cbranch_execz L_warm
    s_mov_b32 s48, 0xb0901410
    s_mov_b32 s49, 0xf0f0f0
    s_mov_b32 s28, 0
    s_mov_b32 s37, 0
    s_mov_b32 s32, 0
    v_mov_b32 v11, 1
    v_mov_b32 v12, 0
    v_mov_b32 v9, 0
    v_mov_b32 v2, 0xff800000
    v_mov_b32 v14, v2
    v_mov_b32 v32, v2
    v_mov_b32 v33, 0
    v_mov_b32 v34, 0
    v_mov_b32 v35, 0
    v_and_b32 v4, 0x1f0, v6
    ds_write_b32 v4, v2 offset:16908
    v_lshlrev_b32 v7, 2, v0
    v_and_b32 v4, 3, v0
    v_cmp_eq_u32 vcc, 0, v4
    v_add_u32 v5, 17920, v7
    v_mov_b32 v4, 0x200
    v_cndmask_b32 v7, v5, v7, vcc
    v_cndmask_b32 v8, 0, v4, vcc
    s_mov_b32 s29, 0x3e0293ee
    v_mov_b32 v3, 0
    v_and_b32 v20, 1, v0
    v_lshlrev_b32 v20, 4, v20
    v_mov_b32 v21, 0xffff
    v_lshlrev_b32 v20, v20, v21
    v_bfe_u32 v21, v0, 1, 2
    v_cmp_eq_u32 s[40:41], 0, v21
    v_cmp_eq_u32 s[42:43], 1, v21
    v_cmp_eq_u32 s[44:45], 2, v21
    v_cmp_eq_u32 s[46:47], 3, v21
    v_cndmask_b32 v24, 0, v20, s[40:41]
    v_cndmask_b32 v25, 0, v20, s[42:43]
    v_cndmask_b32 v26, 0, v20, s[44:45]
    v_cndmask_b32 v27, 0, v20, s[46:47]
    s_xor_b32 s24, s23, 0x1000
    s_waitcnt vmcnt(17)
    buffer_load_dwordx4 v[136:139], v1, s[12:15], s24 offen offset:0 nt
    buffer_load_dwordx4 v[140:143], v1, s[12:15], s24 offen offset:1024 nt
    buffer_load_dwordx4 v[144:147], v1, s[12:15], s24 offen offset:2048 nt
    buffer_load_dwordx4 v[148:151], v1, s[12:15], s24 offen offset:3072 nt
    s_xor_b32 s24, s23, 0x9000
    s_waitcnt vmcnt(16)
    buffer_load_dwordx4 v[152:155], v1, s[12:15], s24 offen offset:0 nt
    buffer_load_dwordx4 v[156:159], v1, s[12:15], s24 offen offset:1024 nt
    buffer_load_dwordx4 v[160:163], v1, s[12:15], s24 offen offset:2048 nt
    buffer_load_dwordx4 v[164:167], v1, s[12:15], s24 offen offset:3072 nt
    s_waitcnt vmcnt(24)
    v_mov_b32_dpp v40, v36 quad_perm:[0,1,2,3] row_mask:0xf bank_mask:0x1
    v_mov_b32_dpp v41, v37 quad_perm:[0,1,2,3] row_mask:0xf bank_mask:0x1
    v_mov_b32_dpp v42, v38 quad_perm:[0,1,2,3] row_mask:0xf bank_mask:0x1
    v_mov_b32_dpp v43, v39 quad_perm:[0,1,2,3] row_mask:0xf bank_mask:0x1
    v_mov_b32_dpp v44, v36 quad_perm:[0,1,2,3] row_mask:0xf bank_mask:0x2
    v_mov_b32_dpp v45, v37 quad_perm:[0,1,2,3] row_mask:0xf bank_mask:0x2
    v_mov_b32_dpp v46, v38 quad_perm:[0,1,2,3] row_mask:0xf bank_mask:0x2
    v_mov_b32_dpp v47, v39 quad_perm:[0,1,2,3] row_mask:0xf bank_mask:0x2
    v_mov_b32_dpp v48, v36 quad_perm:[0,1,2,3] row_mask:0xf bank_mask:0x4
    v_mov_b32_dpp v49, v37 quad_perm:[0,1,2,3] row_mask:0xf bank_mask:0x4
    v_mov_b32_dpp v50, v38 quad_perm:[0,1,2,3] row_mask:0xf bank_mask:0x4
    v_mov_b32_dpp v51, v39 quad_perm:[0,1,2,3] row_mask:0xf bank_mask:0x4
    v_mov_b32_dpp v52, v36 quad_perm:[0,1,2,3] row_mask:0xf bank_mask:0x8
    v_mov_b32_dpp v53, v37 quad_perm:[0,1,2,3] row_mask:0xf bank_mask:0x8
    v_mov_b32_dpp v54, v38 quad_perm:[0,1,2,3] row_mask:0xf bank_mask:0x8
    v_mov_b32_dpp v55, v39 quad_perm:[0,1,2,3] row_mask:0xf bank_mask:0x8
    s_cmp_ge_u32 s2, 8
    s_cbranch_scc1 L_kjoin0
    v_mul_u32_u24 v5, 4352, v0
    v_mov_b32 v11, 0
    v_mov_b32 v10, 1
    s_mov_b64 exec, -4
    global_load_dword v11, v5, s[18:19] sc1
    s_mov_b64 exec, -1
    s_movk_i32 s34, 4352
    s_mov_b32 s33, 5
    s_mov_b32 s38, 0x40014
    s_branch L_kjoin0
L_lead0:
    v_readlane_b32 s35, v11, s28
    v_add_u32 v10, 1, v10
    global_store_dword v9, v10, s[16:17] offset:128
    s_add_u32 s34, s34, 4352
    s_waitcnt lgkmcnt(0)
    s_sub_u32 s38, s33, s35
    s_mov_b32 s33, 1
    s_atomic_add s33, s[18:19], s34 glc
    s_max_i32 s38, s38, 0
    s_min_i32 s38, s38, 7
    s_lshl_b32 s38, s38, 2
    s_or_b32 s38, s38, 0x40000
    s_bfe_i32 s32, 0x1100fffc, s38
    s_cmp_ge_u32 s28, 32
    s_cbranch_scc1 L_vjoin0
    s_branch L_kjoin0
L_lead16:
    v_add_u32 v10, 1, v10
    global_store_dword v9, v10, s[16:17] offset:128
    s_bfe_i32 s32, 0x110fffff, s38
    s_cmp_gt_u32 s28, 32
    s_cbranch_scc1 L_vjoin16
    s_branch L_kjoin16
L_pad_k:
    s_branch L_warm
L_k:
    s_cmp_lt_u32 s2, 8
    s_cbranch_scc1 L_lead0
    v_readfirstlane_b32 s32, v11
    global_load_dword v11, v9, s[16:17] offset:128 sc1
    s_sub_u32 s32, s32, s37
    s_add_u32 s37, s37, 1
L_kjoin0:
    s_add_u32 s28, s28, 1
    s_add_u32 s35, s32, 15
    s_min_u32 s35, s35, 31
    s_lshr_b32 s36, 0xffff7000, s35
    s_and_b32 s36, s36, 1
    s_cmp_le_u32 s32, 15
    s_cselect_b64 vcc, -1, 0
    s_ff1_i32_b32 s35, s28
    s_lshl_b32 s35, s35, 3
    s_lshr_b64 s[26:27], s[48:49], s35
    s_and_b32 s35, s26, 0xff
    s_lshl_b32 s35, s35, 12
    s_xor_b32 s23, s23, s35
    s_mov_b32 s24, s23
    s_cmp_lg_u32 s36, 0
    s_cbranch_vccnz L_khi0
    s_waitcnt vmcnt(18)
    s_cbranch_scc1 L_kgo0
    s_waitcnt vmcnt(16)
L_khi0:
    s_waitcnt vmcnt(24)
    s_cbranch_scc1 L_kgo0
    s_waitcnt vmcnt(20)
L_kgo0:
    buffer_load_dwordx4 v[168:171], v1, s[12:15], s24 offen offset:0 nt
    buffer_load_dwordx4 v[172:175], v1, s[12:15], s24 offen offset:1024 nt
    buffer_load_dwordx4 v[176:179], v1, s[12:15], s24 offen offset:2048 nt
    buffer_load_dwordx4 v[180:183], v1, s[12:15], s24 offen offset:3072 nt
    v_mfma_f32_16x16x32_bf16 v[28:31], v[40:43], v[56:59], 0
    v_add_f32_dpp v15, v33, v32 quad_perm:[1,1,1,1] row_mask:0xf bank_mask:0xf
    v_mfma_f32_16x16x32_bf16 v[28:31], v[44:47], v[60:63], v[28:31]
    v_mfma_f32_16x16x32_bf16 v[28:31], v[48:51], v[64:67], v[28:31]
    v_add_f32_dpp v15, v34, v15 quad_perm:[2,2,2,2] row_mask:0xf bank_mask:0xf
    v_mfma_f32_16x16x32_bf16 v[28:31], v[52:55], v[68:71], v[28:31]
    s_nop 0
    v_add_f32_dpp v15, v35, v15 quad_perm:[3,3,3,3] row_mask:0xf bank_mask:0xf
    ds_write2_b32 v7, v14, v15 offset0:130 offset1:194
    v_max3_f32 v2, v14, v15, v2
    v_add_u32 v7, v8, v7
    s_cmp_eq_u32 s28, 32
    s_cselect_b32 s12, s20, s12
    s_cselect_b32 s13, s21, s13
    s_cselect_b64 s[26:27], -1, 0
    v_cndmask_b32 v1, v1, v6, s[26:27]
    s_xor_b32 s24, s23, 0x8000
    s_cmp_lg_u32 s36, 0
    s_cbranch_vccnz L_khi4
    s_waitcnt vmcnt(17)
    s_cbranch_scc1 L_kgo4
    s_waitcnt vmcnt(16)
L_khi4:
    s_waitcnt vmcnt(24)
    s_cbranch_scc1 L_kgo4
    s_waitcnt vmcnt(19)
L_kgo4:
    buffer_load_dwordx4 v[56:59], v1, s[12:15], s24 offen offset:0 nt
    buffer_load_dwordx4 v[60:63], v1, s[12:15], s24 offen offset:1024 nt
    buffer_load_dwordx4 v[64:67], v1, s[12:15], s24 offen offset:2048 nt
    buffer_load_dwordx4 v[68:71], v1, s[12:15], s24 offen offset:3072 nt
    v_mfma_f32_16x16x32_bf16 v[32:35], v[40:43], v[72:75], 0
    v_add_f32_dpp v14, v29, v28 quad_perm:[1,1,1,1] row_mask:0xf bank_mask:0xf
    v_mfma_f32_16x16x32_bf16 v[32:35], v[44:47], v[76:79], v[32:35]
    v_mfma_f32_16x16x32_bf16 v[32:35], v[48:51], v[80:83], v[32:35]
    v_add_f32_dpp v14, v30, v14 quad_perm:[2,2,2,2] row_mask:0xf bank_mask:0xf
    v_mfma_f32_16x16x32_bf16 v[32:35], v[52:55], v[84:87], v[32:35]
    s_nop 0
    v_add_f32_dpp v14, v31, v14 quad_perm:[3,3,3,3] row_mask:0xf bank_mask:0xf
    s_xor_b32 s24, s23, 0x2000
    s_cmp_lg_u32 s36, 0
    s_cbranch_vccnz L_khi8
    s_waitcnt vmcnt(17)
    s_cbranch_scc1 L_kgo8
    s_waitcnt vmcnt(16)
L_khi8:
    s_waitcnt vmcnt(24)
    s_cbranch_scc1 L_kgo8
    s_waitcnt vmcnt(19)
L_kgo8:
    buffer_load_dwordx4 v[72:75], v1, s[12:15], s24 offen offset:0 nt
    buffer_load_dwordx4 v[76:79], v1, s[12:15], s24 offen offset:1024 nt
    buffer_load_dwordx4 v[80:83], v1, s[12:15], s24 offen offset:2048 nt
    buffer_load_dwordx4 v[84:87], v1, s[12:15], s24 offen offset:3072 nt
    v_mfma_f32_16x16x32_bf16 v[28:31], v[40:43], v[88:91], 0
    v_add_f32_dpp v15, v33, v32 quad_perm:[1,1,1,1] row_mask:0xf bank_mask:0xf
    v_mfma_f32_16x16x32_bf16 v[28:31], v[44:47], v[92:95], v[28:31]
    v_mfma_f32_16x16x32_bf16 v[28:31], v[48:51], v[96:99], v[28:31]
    v_add_f32_dpp v15, v34, v15 quad_perm:[2,2,2,2] row_mask:0xf bank_mask:0xf
    v_mfma_f32_16x16x32_bf16 v[28:31], v[52:55], v[100:103], v[28:31]
    s_nop 0
    v_add_f32_dpp v15, v35, v15 quad_perm:[3,3,3,3] row_mask:0xf bank_mask:0xf
    ds_write2_b32 v7, v14, v15 offset0:3 offset1:67
    v_max3_f32 v2, v14, v15, v2
    s_xor_b32 s24, s23, 0xa000
    s_cmp_lg_u32 s36, 0
    s_cbranch_vccnz L_khi12
    s_waitcnt vmcnt(17)
    s_cbranch_scc1 L_kgo12
    s_waitcnt vmcnt(16)
L_khi12:
    s_waitcnt vmcnt(24)
    s_cbranch_scc1 L_kgo12
    s_waitcnt vmcnt(19)
L_kgo12:
    buffer_load_dwordx4 v[88:91], v1, s[12:15], s24 offen offset:0 nt
    buffer_load_dwordx4 v[92:95], v1, s[12:15], s24 offen offset:1024 nt
    buffer_load_dwordx4 v[96:99], v1, s[12:15], s24 offen offset:2048 nt
    buffer_load_dwordx4 v[100:103], v1, s[12:15], s24 offen offset:3072 nt
    v_mfma_f32_16x16x32_bf16 v[32:35], v[40:43], v[104:107], 0
    v_add_f32_dpp v14, v29, v28 quad_perm:[1,1,1,1] row_mask:0xf bank_mask:0xf
    v_mfma_f32_16x16x32_bf16 v[32:35], v[44:47], v[108:111], v[32:35]
    v_mfma_f32_16x16x32_bf16 v[32:35], v[48:51], v[112:115], v[32:35]
    v_add_f32_dpp v14, v30, v14 quad_perm:[2,2,2,2] row_mask:0xf bank_mask:0xf
    v_mfma_f32_16x16x32_bf16 v[32:35], v[52:55], v[116:119], v[32:35]
    s_nop 0
    v_add_f32_dpp v14, v31, v14 quad_perm:[3,3,3,3] row_mask:0xf bank_mask:0xf
    s_cmp_lt_u32 s2, 8
    s_cbranch_scc1 L_lead16
    v_readfirstlane_b32 s32, v12
    global_load_dword v12, v9, s[16:17] offset:128 sc1
    s_sub_u32 s32, s32, s37
    s_add_u32 s37, s37, 1
L_kjoin16:
    s_add_u32 s35, s32, 15
    s_min_u32 s35, s35, 31
    s_lshr_b32 s36, 0xffff7000, s35
    s_and_b32 s36, s36, 1
    s_cmp_le_u32 s32, 15
    s_cselect_b64 vcc, -1, 0
    s_xor_b32 s24, s23, 0x3000
L_pad_k16:
    s_cbranch_execz L_warm
    s_cmp_lg_u32 s36, 0
    s_cbranch_vccnz L_khi16
    s_waitcnt vmcnt(18)
    s_cbranch_scc1 L_kgo16
    s_waitcnt vmcnt(16)
L_khi16:
    s_waitcnt vmcnt(24)
    s_cbranch_scc1 L_kgo16
    s_waitcnt vmcnt(20)
L_kgo16:
    buffer_load_dwordx4 v[104:107], v1, s[12:15], s24 offen offset:0 nt
    buffer_load_dwordx4 v[108:111], v1, s[12:15], s24 offen offset:1024 nt
    buffer_load_dwordx4 v[112:115], v1, s[12:15], s24 offen offset:2048 nt
    buffer_load_dwordx4 v[116:119], v1, s[12:15], s24 offen offset:3072 nt
    v_mfma_f32_16x16x32_bf16 v[28:31], v[40:43], v[120:123], 0
    v_add_f32_dpp v15, v33, v32 quad_perm:[1,1,1,1] row_mask:0xf bank_mask:0xf
    v_mfma_f32_16x16x32_bf16 v[28:31], v[44:47], v[124:127], v[28:31]
    v_mfma_f32_16x16x32_bf16 v[28:31], v[48:51], v[128:131], v[28:31]
    v_add_f32_dpp v15, v34, v15 quad_perm:[2,2,2,2] row_mask:0xf bank_mask:0xf
    v_mfma_f32_16x16x32_bf16 v[28:31], v[52:55], v[132:135], v[28:31]
    s_nop 0
    v_add_f32_dpp v15, v35, v15 quad_perm:[3,3,3,3] row_mask:0xf bank_mask:0xf
    ds_write2_b32 v7, v14, v15 offset0:128 offset1:192
    v_max3_f32 v2, v14, v15, v2
    s_xor_b32 s24, s23, 0xb000
    s_cmp_lg_u32 s36, 0
    s_cbranch_vccnz L_khi20
    s_waitcnt vmcnt(17)
    s_cbranch_scc1 L_kgo20
    s_waitcnt vmcnt(16)
L_khi20:
    s_waitcnt vmcnt(24)
    s_cbranch_scc1 L_kgo20
    s_waitcnt vmcnt(19)
L_kgo20:
    buffer_load_dwordx4 v[120:123], v1, s[12:15], s24 offen offset:0 nt
    buffer_load_dwordx4 v[124:127], v1, s[12:15], s24 offen offset:1024 nt
    buffer_load_dwordx4 v[128:131], v1, s[12:15], s24 offen offset:2048 nt
    buffer_load_dwordx4 v[132:135], v1, s[12:15], s24 offen offset:3072 nt
    v_mfma_f32_16x16x32_bf16 v[32:35], v[40:43], v[136:139], 0
    v_add_f32_dpp v14, v29, v28 quad_perm:[1,1,1,1] row_mask:0xf bank_mask:0xf
    v_mfma_f32_16x16x32_bf16 v[32:35], v[44:47], v[140:143], v[32:35]
    v_mfma_f32_16x16x32_bf16 v[32:35], v[48:51], v[144:147], v[32:35]
    v_add_f32_dpp v14, v30, v14 quad_perm:[2,2,2,2] row_mask:0xf bank_mask:0xf
    v_mfma_f32_16x16x32_bf16 v[32:35], v[52:55], v[148:151], v[32:35]
    s_nop 0
    v_add_f32_dpp v14, v31, v14 quad_perm:[3,3,3,3] row_mask:0xf bank_mask:0xf
    s_xor_b32 s24, s23, 0x1000
    s_cmp_lg_u32 s36, 0
    s_cbranch_vccnz L_khi24
    s_waitcnt vmcnt(17)
    s_cbranch_scc1 L_kgo24
    s_waitcnt vmcnt(16)
L_khi24:
    s_waitcnt vmcnt(24)
    s_cbranch_scc1 L_kgo24
    s_waitcnt vmcnt(19)
L_kgo24:
    buffer_load_dwordx4 v[136:139], v1, s[12:15], s24 offen offset:0 nt
    buffer_load_dwordx4 v[140:143], v1, s[12:15], s24 offen offset:1024 nt
    buffer_load_dwordx4 v[144:147], v1, s[12:15], s24 offen offset:2048 nt
    buffer_load_dwordx4 v[148:151], v1, s[12:15], s24 offen offset:3072 nt
    v_mfma_f32_16x16x32_bf16 v[28:31], v[40:43], v[152:155], 0
    v_add_f32_dpp v15, v33, v32 quad_perm:[1,1,1,1] row_mask:0xf bank_mask:0xf
    v_mfma_f32_16x16x32_bf16 v[28:31], v[44:47], v[156:159], v[28:31]
    v_mfma_f32_16x16x32_bf16 v[28:31], v[48:51], v[160:163], v[28:31]
    v_add_f32_dpp v15, v34, v15 quad_perm:[2,2,2,2] row_mask:0xf bank_mask:0xf
    v_mfma_f32_16x16x32_bf16 v[28:31], v[52:55], v[164:167], v[28:31]
    s_nop 0
    v_add_f32_dpp v15, v35, v15 quad_perm:[3,3,3,3] row_mask:0xf bank_mask:0xf
    ds_write2_b32 v7, v14, v15 offset0:129 offset1:193
    v_max3_f32 v2, v14, v15, v2
    s_xor_b32 s24, s23, 0x9000
    s_cmp_lg_u32 s36, 0
    s_cbranch_vccnz L_khi28
    s_waitcnt vmcnt(17)
    s_cbranch_scc1 L_kgo28
    s_waitcnt vmcnt(16)
L_khi28:
    s_waitcnt vmcnt(24)
    s_cbranch_scc1 L_kgo28
    s_waitcnt vmcnt(19)
L_kgo28:
    buffer_load_dwordx4 v[152:155], v1, s[12:15], s24 offen offset:0 nt
    buffer_load_dwordx4 v[156:159], v1, s[12:15], s24 offen offset:1024 nt
    buffer_load_dwordx4 v[160:163], v1, s[12:15], s24 offen offset:2048 nt
    buffer_load_dwordx4 v[164:167], v1, s[12:15], s24 offen offset:3072 nt
    v_mfma_f32_16x16x32_bf16 v[32:35], v[40:43], v[168:171], 0
    v_add_f32_dpp v14, v29, v28 quad_perm:[1,1,1,1] row_mask:0xf bank_mask:0xf
    v_mfma_f32_16x16x32_bf16 v[32:35], v[44:47], v[172:175], v[32:35]
    v_mfma_f32_16x16x32_bf16 v[32:35], v[48:51], v[176:179], v[32:35]
    v_add_f32_dpp v14, v30, v14 quad_perm:[2,2,2,2] row_mask:0xf bank_mask:0xf
    v_mfma_f32_16x16x32_bf16 v[32:35], v[52:55], v[180:183], v[32:35]
    s_nop 0
    v_add_f32_dpp v14, v31, v14 quad_perm:[3,3,3,3] row_mask:0xf bank_mask:0xf
    s_cmp_lg_u32 s28, 32
    s_cbranch_scc1 L_k
    v_and_b32 v8, 0xf0, v6
    v_lshrrev_b32 v5, 4, v0
    v_lshl_add_u32 v8, v5, 3, v8
    v_add_u32 v8, s31, v8
    v_and_b32 v4, 3, v0
    v_lshlrev_b32 v13, 7, v4
    v_add_f32_dpp v15, v33, v32 quad_perm:[1,1,1,1] row_mask:0xf bank_mask:0xf
    v_and_b32 v4, 8, v0
    v_lshl_add_u32 v13, v4, 3, v13
    v_add_f32_dpp v15, v34, v15 quad_perm:[2,2,2,2] row_mask:0xf bank_mask:0xf
    v_and_b32 v4, 48, v0
    v_add_u32 v13, v4, v13
    v_add_f32_dpp v15, v35, v15 quad_perm:[3,3,3,3] row_mask:0xf bank_mask:0xf
    ds_write2_b32 v7, v14, v15 offset0:130 offset1:194
    v_max3_f32 v2, v14, v15, v2
L_pad_t:
    s_cbranch_execz L_warm
    ds_read_b32 v23, v13 offset:524
    ds_read_b128 v[16:19], v13 offset:1024
    v_mov_b32_dpp v2, v2 quad_perm:[0,0,0,0] row_mask:0xf bank_mask:0xf
    v_mov_b32 v28, 0
    v_mov_b32 v29, 0
    v_max_f32_dpp v2, v2, v2 row_ror:8 row_mask:0xf bank_mask:0xf
    v_mov_b32 v30, 0
    v_mov_b32 v31, 0
    v_max_f32_dpp v2, v2, v2 row_ror:4 row_mask:0xf bank_mask:0xf
    v_mov_b32 v4, v2
    v_mov_b32 v32, 0
    v_mov_b32 v33, 0
    v_permlane32_swap_b32 v4, v2
    v_max_f32 v2, v4, v2
    v_mov_b32 v4, v2
    v_mov_b32 v34, 0
    v_mov_b32 v35, 0
    v_permlane16_swap_b32 v4, v2
    v_max_f32 v2, v4, v2
    s_waitcnt lgkmcnt(0)
    v_sub_f32 v23, v23, v2
    v_mul_f32 v23, s29, v23
    v_exp_f32 v23, v23
    s_nop 0
    v_add_f32 v3, v3, v23
    v_cvt_pk_bf16_f32 v23, v23, v23
    s_nop 1
    v_and_b32_dpp v40, v23, v24 quad_perm:[0,0,0,0] row_mask:0xf bank_mask:0xf
    v_and_b32_dpp v41, v23, v25 quad_perm:[0,0,0,0] row_mask:0xf bank_mask:0xf
    v_and_b32_dpp v42, v23, v26 quad_perm:[0,0,0,0] row_mask:0xf bank_mask:0xf
    v_and_b32_dpp v43, v23, v27 quad_perm:[0,0,0,0] row_mask:0xf bank_mask:0xf
    v_and_b32_dpp v44, v23, v24 quad_perm:[1,1,1,1] row_mask:0xf bank_mask:0xf
    v_and_b32_dpp v45, v23, v25 quad_perm:[1,1,1,1] row_mask:0xf bank_mask:0xf
    v_and_b32_dpp v46, v23, v26 quad_perm:[1,1,1,1] row_mask:0xf bank_mask:0xf
    v_and_b32_dpp v47, v23, v27 quad_perm:[1,1,1,1] row_mask:0xf bank_mask:0xf
L_v:
    s_waitcnt lgkmcnt(0)
    s_cmp_eq_u32 s28, 63
    s_cselect_b32 s32, 0, s32
    s_cbranch_scc1 L_vjoin0
    s_cmp_lt_u32 s2, 8
    s_cbranch_scc1 L_lead0
    v_readfirstlane_b32 s32, v11
    global_load_dword v11, v9, s[16:17] offset:128 sc1
    s_sub_u32 s32, s32, s37
    s_add_u32 s37, s37, 1
L_vjoin0:
    s_add_u32 s28, s28, 1
    s_add_u32 s35, s32, 15
    s_min_u32 s35, s35, 31
    s_lshr_b32 s36, 0xffff7000, s35
    s_and_b32 s36, s36, 1
    s_cmp_le_u32 s32, 15
    s_cselect_b64 vcc, -1, 0
    s_ff1_i32_b32 s35, s28
    s_lshl_b32 s35, s35, 3
    s_lshr_b64 s[26:27], s[48:49], s35
    s_and_b32 s35, s26, 0xff
    s_lshl_b32 s35, s35, 12
    s_xor_b32 s23, s23, s35
    s_mov_b32 s24, s23
    s_cmp_lg_u32 s36, 0
    s_cbranch_vccnz L_vhi0
    s_waitcnt vmcnt(18)
    s_cbranch_scc1 L_vgo0
    s_waitcnt vmcnt(16)
L_vhi0:
    s_waitcnt vmcnt(24)
    s_cbranch_scc1 L_vgo0
    s_waitcnt vmcnt(21)
L_vgo0:
    buffer_load_dwordx4 v[168:171], v1, s[12:15], s24 offen offset:0 nt
    buffer_load_dwordx4 v[172:175], v1, s[12:15], s24 offen offset:1024 nt
    buffer_load_dwordx4 v[176:179], v1, s[12:15], s24 offen offset:2048 nt
    buffer_load_dwordx4 v[180:183], v1, s[12:15], s24 offen offset:3072 nt
    v_mfma_f32_16x16x32_bf16 v[28:31], v[40:43], v[56:59], v[28:31]
    v_and_b32_dpp v48, v23, v24 quad_perm:[2,2,2,2] row_mask:0xf bank_mask:0xf
    v_sub_f32 v20, v16, v2
    v_mul_f32 v20, s29, v20
    v_and_b32_dpp v49, v23, v25 quad_perm:[2,2,2,2] row_mask:0xf bank_mask:0xf
    v_mfma_f32_16x16x32_bf16 v[32:35], v[40:43], v[60:63], v[32:35]
    v_and_b32_dpp v50, v23, v26 quad_perm:[2,2,2,2] row_mask:0xf bank_mask:0xf
    v_exp_f32 v20, v20
    v_and_b32_dpp v51, v23, v27 quad_perm:[2,2,2,2] row_mask:0xf bank_mask:0xf
    v_mfma_f32_16x16x32_bf16 v[28:31], v[44:47], v[64:67], v[28:31]
    v_and_b32_dpp v52, v23, v24 quad_perm:[3,3,3,3] row_mask:0xf bank_mask:0xf
    v_add_f32 v3, v3, v20
    v_and_b32_dpp v53, v23, v25 quad_perm:[3,3,3,3] row_mask:0xf bank_mask:0xf
    v_mfma_f32_16x16x32_bf16 v[32:35], v[44:47], v[68:71], v[32:35]
    v_and_b32_dpp v54, v23, v26 quad_perm:[3,3,3,3] row_mask:0xf bank_mask:0xf
    v_cvt_pk_bf16_f32 v20, v20, v20
    v_and_b32_dpp v55, v23, v27 quad_perm:[3,3,3,3] row_mask:0xf bank_mask:0xf
    s_xor_b32 s24, s23, 0x8000
    s_cmp_lg_u32 s36, 0
    s_cbranch_vccnz L_vhi4
    s_waitcnt vmcnt(17)
    s_cbranch_scc1 L_vgo4
    s_waitcnt vmcnt(16)
L_vhi4:
    s_waitcnt vmcnt(24)
    s_cbranch_scc1 L_vgo4
    s_waitcnt vmcnt(20)
L_vgo4:
    s_cmp_eq_u32 s28, 64
    s_cselect_b32 s14, 0, s14
    s_cbranch_scc1 L_vnold4
    buffer_load_dwordx4 v[56:59], v1, s[12:15], s24 offen offset:0 nt
    buffer_load_dwordx4 v[60:63], v1, s[12:15], s24 offen offset:1024 nt
    buffer_load_dwordx4 v[64:67], v1, s[12:15], s24 offen offset:2048 nt
    buffer_load_dwordx4 v[68:71], v1, s[12:15], s24 offen offset:3072 nt
L_vnold4:
    v_mfma_f32_16x16x32_bf16 v[28:31], v[48:51], v[72:75], v[28:31]
    v_and_b32_dpp v40, v20, v24 quad_perm:[0,0,0,0] row_mask:0xf bank_mask:0xf
    v_sub_f32 v21, v17, v2
    v_mul_f32 v21, s29, v21
    v_and_b32_dpp v41, v20, v25 quad_perm:[0,0,0,0] row_mask:0xf bank_mask:0xf
    v_mfma_f32_16x16x32_bf16 v[32:35], v[48:51], v[76:79], v[32:35]
    v_and_b32_dpp v42, v20, v26 quad_perm:[0,0,0,0] row_mask:0xf bank_mask:0xf
    v_sub_f32 v22, v18, v2
    v_mul_f32 v22, s29, v22
    v_and_b32_dpp v43, v20, v27 quad_perm:[0,0,0,0] row_mask:0xf bank_mask:0xf
    v_mfma_f32_16x16x32_bf16 v[28:31], v[52:55], v[80:83], v[28:31]
    v_and_b32_dpp v44, v20, v24 quad_perm:[1,1,1,1] row_mask:0xf bank_mask:0xf
    v_sub_f32 v23, v19, v2
    v_mul_f32 v23, s29, v23
    v_and_b32_dpp v45, v20, v25 quad_perm:[1,1,1,1] row_mask:0xf bank_mask:0xf
    v_mfma_f32_16x16x32_bf16 v[32:35], v[52:55], v[84:87], v[32:35]
    v_and_b32_dpp v46, v20, v26 quad_perm:[1,1,1,1] row_mask:0xf bank_mask:0xf
    v_exp_f32 v21, v21
    v_and_b32_dpp v47, v20, v27 quad_perm:[1,1,1,1] row_mask:0xf bank_mask:0xf
    s_xor_b32 s24, s23, 0x2000
    s_cmp_lg_u32 s36, 0
    s_cbranch_vccnz L_vhi8
    s_waitcnt vmcnt(17)
    s_cbranch_scc1 L_vgo8
    s_waitcnt vmcnt(16)
L_vhi8:
    s_waitcnt vmcnt(24)
    s_cbranch_scc1 L_vgo8
    s_waitcnt vmcnt(20)
L_vgo8:
    buffer_load_dwordx4 v[72:75], v1, s[12:15], s24 offen offset:0 nt
    buffer_load_dwordx4 v[76:79], v1, s[12:15], s24 offen offset:1024 nt
    buffer_load_dwordx4 v[80:83], v1, s[12:15], s24 offen offset:2048 nt
    buffer_load_dwordx4 v[84:87], v1, s[12:15], s24 offen offset:3072 nt
    v_mfma_f32_16x16x32_bf16 v[28:31], v[40:43], v[88:91], v[28:31]
    v_and_b32_dpp v48, v20, v24 quad_perm:[2,2,2,2] row_mask:0xf bank_mask:0xf
    ds_read_b128 v[16:19], v13 offset:1536
    v_and_b32_dpp v49, v20, v25 quad_perm:[2,2,2,2] row_mask:0xf bank_mask:0xf
    v_mfma_f32_16x16x32_bf16 v[32:35], v[40:43], v[92:95], v[32:35]
    v_and_b32_dpp v50, v20, v26 quad_perm:[2,2,2,2] row_mask:0xf bank_mask:0xf
    v_add_u32 v13, 0x200, v13
    v_and_b32_dpp v51, v20, v27 quad_perm:[2,2,2,2] row_mask:0xf bank_mask:0xf
    v_mfma_f32_16x16x32_bf16 v[28:31], v[44:47], v[96:99], v[28:31]
    v_and_b32_dpp v52, v20, v24 quad_perm:[3,3,3,3] row_mask:0xf bank_mask:0xf
    v_add_f32 v3, v3, v21
    v_and_b32_dpp v53, v20, v25 quad_perm:[3,3,3,3] row_mask:0xf bank_mask:0xf
    v_mfma_f32_16x16x32_bf16 v[32:35], v[44:47], v[100:103], v[32:35]
    v_and_b32_dpp v54, v20, v26 quad_perm:[3,3,3,3] row_mask:0xf bank_mask:0xf
    v_cvt_pk_bf16_f32 v21, v21, v21
    v_and_b32_dpp v55, v20, v27 quad_perm:[3,3,3,3] row_mask:0xf bank_mask:0xf
    s_xor_b32 s24, s23, 0xa000
    s_cmp_lg_u32 s36, 0
    s_cbranch_vccnz L_vhi12
    s_waitcnt vmcnt(17)
    s_cbranch_scc1 L_vgo12
    s_waitcnt vmcnt(16)
L_vhi12:
    s_waitcnt vmcnt(24)
    s_cbranch_scc1 L_vgo12
    s_waitcnt vmcnt(20)
L_vgo12:
    buffer_load_dwordx4 v[88:91], v1, s[12:15], s24 offen offset:0 nt
    buffer_load_dwordx4 v[92:95], v1, s[12:15], s24 offen offset:1024 nt
    buffer_load_dwordx4 v[96:99], v1, s[12:15], s24 offen offset:2048 nt
    buffer_load_dwordx4 v[100:103], v1, s[12:15], s24 offen offset:3072 nt
    v_mfma_f32_16x16x32_bf16 v[28:31], v[48:51], v[104:107], v[28:31]
    v_and_b32_dpp v40, v21, v24 quad_perm:[0,0,0,0] row_mask:0xf bank_mask:0xf
    v_exp_f32 v22, v22
    v_and_b32_dpp v41, v21, v25 quad_perm:[0,0,0,0] row_mask:0xf bank_mask:0xf
    v_mfma_f32_16x16x32_bf16 v[32:35], v[48:51], v[108:111], v[32:35]
    v_and_b32_dpp v42, v21, v26 quad_perm:[0,0,0,0] row_mask:0xf bank_mask:0xf
    v_exp_f32 v23, v23
    v_and_b32_dpp v43, v21, v27 quad_perm:[0,0,0,0] row_mask:0xf bank_mask:0xf
    v_mfma_f32_16x16x32_bf16 v[28:31], v[52:55], v[112:115], v[28:31]
    v_and_b32_dpp v44, v21, v24 quad_perm:[1,1,1,1] row_mask:0xf bank_mask:0xf
    v_add_f32 v3, v3, v22
    v_and_b32_dpp v45, v21, v25 quad_perm:[1,1,1,1] row_mask:0xf bank_mask:0xf
    v_mfma_f32_16x16x32_bf16 v[32:35], v[52:55], v[116:119], v[32:35]
    v_and_b32_dpp v46, v21, v26 quad_perm:[1,1,1,1] row_mask:0xf bank_mask:0xf
    v_cvt_pk_bf16_f32 v22, v22, v22
    v_and_b32_dpp v47, v21, v27 quad_perm:[1,1,1,1] row_mask:0xf bank_mask:0xf
    s_cmp_lg_u32 s28, 64
    s_cbranch_scc1 L_vnorm16
    s_waitcnt vmcnt(20)
    s_branch L_vjoin16
L_pad_v:
    s_branch L_warm
L_vnorm16:
    s_cmp_lt_u32 s2, 8
    s_cbranch_scc1 L_lead16
    v_readfirstlane_b32 s32, v12
    global_load_dword v12, v9, s[16:17] offset:128 sc1
    s_sub_u32 s32, s32, s37
    s_add_u32 s37, s37, 1
L_vjoin16:
    s_add_u32 s35, s32, 15
    s_min_u32 s35, s35, 31
    s_lshr_b32 s36, 0xffff7000, s35
    s_and_b32 s36, s36, 1
    s_cmp_le_u32 s32, 15
    s_cselect_b64 vcc, -1, 0
    s_xor_b32 s24, s23, 0x3000
    s_cmp_lg_u32 s36, 0
    s_cbranch_vccnz L_vhi16
    s_waitcnt vmcnt(18)
    s_cbranch_scc1 L_vgo16
    s_waitcnt vmcnt(16)
L_vhi16:
    s_waitcnt vmcnt(24)
    s_cbranch_scc1 L_vgo16
    s_waitcnt vmcnt(21)
L_vgo16:
    buffer_load_dwordx4 v[104:107], v1, s[12:15], s24 offen offset:0 nt
    buffer_load_dwordx4 v[108:111], v1, s[12:15], s24 offen offset:1024 nt
    buffer_load_dwordx4 v[112:115], v1, s[12:15], s24 offen offset:2048 nt
    buffer_load_dwordx4 v[116:119], v1, s[12:15], s24 offen offset:3072 nt
    v_mfma_f32_16x16x32_bf16 v[28:31], v[40:43], v[120:123], v[28:31]
    v_and_b32_dpp v48, v21, v24 quad_perm:[2,2,2,2] row_mask:0xf bank_mask:0xf
    v_add_f32 v3, v3, v23
    v_and_b32_dpp v49, v21, v25 quad_perm:[2,2,2,2] row_mask:0xf bank_mask:0xf
    v_mfma_f32_16x16x32_bf16 v[32:35], v[40:43], v[124:127], v[32:35]
    v_and_b32_dpp v50, v21, v26 quad_perm:[2,2,2,2] row_mask:0xf bank_mask:0xf
    v_cvt_pk_bf16_f32 v23, v23, v23
    v_and_b32_dpp v51, v21, v27 quad_perm:[2,2,2,2] row_mask:0xf bank_mask:0xf
    v_mfma_f32_16x16x32_bf16 v[28:31], v[44:47], v[128:131], v[28:31]
    v_and_b32_dpp v52, v21, v24 quad_perm:[3,3,3,3] row_mask:0xf bank_mask:0xf
    v_add_f32_dpp v4, v3, v3 row_ror:8 row_mask:0xf bank_mask:0xf
    v_and_b32_dpp v53, v21, v25 quad_perm:[3,3,3,3] row_mask:0xf bank_mask:0xf
    v_mfma_f32_16x16x32_bf16 v[32:35], v[44:47], v[132:135], v[32:35]
    v_and_b32_dpp v54, v21, v26 quad_perm:[3,3,3,3] row_mask:0xf bank_mask:0xf
    v_add_f32_dpp v4, v4, v4 quad_perm:[2,3,0,1] row_mask:0xf bank_mask:0xf
    v_and_b32_dpp v55, v21, v27 quad_perm:[3,3,3,3] row_mask:0xf bank_mask:0xf
    s_xor_b32 s24, s23, 0xb000
    s_cmp_lg_u32 s36, 0
    s_cbranch_vccnz L_vhi20
    s_waitcnt vmcnt(17)
    s_cbranch_scc1 L_vgo20
    s_waitcnt vmcnt(16)
L_vhi20:
    s_waitcnt vmcnt(24)
    s_cbranch_scc1 L_vgo20
    s_waitcnt vmcnt(20)
L_vgo20:
    buffer_load_dwordx4 v[120:123], v1, s[12:15], s24 offen offset:0 nt
    buffer_load_dwordx4 v[124:127], v1, s[12:15], s24 offen offset:1024 nt
    buffer_load_dwordx4 v[128:131], v1, s[12:15], s24 offen offset:2048 nt
    buffer_load_dwordx4 v[132:135], v1, s[12:15], s24 offen offset:3072 nt
    v_mfma_f32_16x16x32_bf16 v[28:31], v[48:51], v[136:139], v[28:31]
    v_and_b32_dpp v40, v22, v24 quad_perm:[0,0,0,0] row_mask:0xf bank_mask:0xf
    v_add_f32_dpp v4, v4, v4 quad_perm:[1,0,3,2] row_mask:0xf bank_mask:0xf
    v_and_b32_dpp v41, v22, v25 quad_perm:[0,0,0,0] row_mask:0xf bank_mask:0xf
    v_mfma_f32_16x16x32_bf16 v[32:35], v[48:51], v[140:143], v[32:35]
    v_and_b32_dpp v42, v22, v26 quad_perm:[0,0,0,0] row_mask:0xf bank_mask:0xf
    v_mov_b32 v5, v4
    v_and_b32_dpp v43, v22, v27 quad_perm:[0,0,0,0] row_mask:0xf bank_mask:0xf
    v_mfma_f32_16x16x32_bf16 v[28:31], v[52:55], v[144:147], v[28:31]
    v_and_b32_dpp v44, v22, v24 quad_perm:[1,1,1,1] row_mask:0xf bank_mask:0xf
    v_permlane32_swap_b32 v4, v5
    v_and_b32_dpp v45, v22, v25 quad_perm:[1,1,1,1] row_mask:0xf bank_mask:0xf
    v_mfma_f32_16x16x32_bf16 v[32:35], v[52:55], v[148:151], v[32:35]
    v_and_b32_dpp v46, v22, v26 quad_perm:[1,1,1,1] row_mask:0xf bank_mask:0xf
    v_add_f32 v4, v4, v5
    v_and_b32_dpp v47, v22, v27 quad_perm:[1,1,1,1] row_mask:0xf bank_mask:0xf
    s_xor_b32 s24, s23, 0x1000
    s_cmp_lg_u32 s36, 0
    s_cbranch_vccnz L_vhi24
    s_waitcnt vmcnt(17)
    s_cbranch_scc1 L_vgo24
    s_waitcnt vmcnt(16)
L_vhi24:
    s_waitcnt vmcnt(24)
    s_cbranch_scc1 L_vgo24
    s_waitcnt vmcnt(20)
L_vgo24:
    buffer_load_dwordx4 v[136:139], v1, s[12:15], s24 offen offset:0 nt
    buffer_load_dwordx4 v[140:143], v1, s[12:15], s24 offen offset:1024 nt
    buffer_load_dwordx4 v[144:147], v1, s[12:15], s24 offen offset:2048 nt
    buffer_load_dwordx4 v[148:151], v1, s[12:15], s24 offen offset:3072 nt
    v_mfma_f32_16x16x32_bf16 v[28:31], v[40:43], v[152:155], v[28:31]
    v_and_b32_dpp v48, v22, v24 quad_perm:[2,2,2,2] row_mask:0xf bank_mask:0xf
    v_mov_b32 v5, v4
    v_and_b32_dpp v49, v22, v25 quad_perm:[2,2,2,2] row_mask:0xf bank_mask:0xf
    v_mfma_f32_16x16x32_bf16 v[32:35], v[40:43], v[156:159], v[32:35]
    v_and_b32_dpp v50, v22, v26 quad_perm:[2,2,2,2] row_mask:0xf bank_mask:0xf
    v_permlane16_swap_b32 v4, v5
    v_and_b32_dpp v51, v22, v27 quad_perm:[2,2,2,2] row_mask:0xf bank_mask:0xf
    v_mfma_f32_16x16x32_bf16 v[28:31], v[44:47], v[160:163], v[28:31]
    v_and_b32_dpp v52, v22, v24 quad_perm:[3,3,3,3] row_mask:0xf bank_mask:0xf
    v_add_f32 v4, v4, v5
    v_and_b32_dpp v53, v22, v25 quad_perm:[3,3,3,3] row_mask:0xf bank_mask:0xf
    v_mfma_f32_16x16x32_bf16 v[32:35], v[44:47], v[164:167], v[32:35]
    v_and_b32_dpp v54, v22, v26 quad_perm:[3,3,3,3] row_mask:0xf bank_mask:0xf
    v_rcp_f32 v4, v4
    v_and_b32_dpp v55, v22, v27 quad_perm:[3,3,3,3] row_mask:0xf bank_mask:0xf
    s_xor_b32 s24, s23, 0x9000
    s_cmp_lg_u32 s36, 0
    s_cbranch_vccnz L_vhi28
    s_waitcnt vmcnt(17)
    s_cbranch_scc1 L_vgo28
    s_waitcnt vmcnt(16)
L_vhi28:
    s_waitcnt vmcnt(24)
    s_cbranch_scc1 L_vgo28
    s_waitcnt vmcnt(20)
L_vgo28:
    s_cmp_eq_u32 s28, 64
    s_cbranch_scc1 L_vnold28
    buffer_load_dwordx4 v[152:155], v1, s[12:15], s24 offen offset:0 nt
    buffer_load_dwordx4 v[156:159], v1, s[12:15], s24 offen offset:1024 nt
    buffer_load_dwordx4 v[160:163], v1, s[12:15], s24 offen offset:2048 nt
    buffer_load_dwordx4 v[164:167], v1, s[12:15], s24 offen offset:3072 nt
L_vnold28:
    v_mfma_f32_16x16x32_bf16 v[28:31], v[48:51], v[168:171], v[28:31]
    v_and_b32_dpp v40, v23, v24 quad_perm:[0,0,0,0] row_mask:0xf bank_mask:0xf
    v_and_b32_dpp v41, v23, v25 quad_perm:[0,0,0,0] row_mask:0xf bank_mask:0xf
    v_mfma_f32_16x16x32_bf16 v[32:35], v[48:51], v[172:175], v[32:35]
    v_and_b32_dpp v42, v23, v26 quad_perm:[0,0,0,0] row_mask:0xf bank_mask:0xf
    v_and_b32_dpp v43, v23, v27 quad_perm:[0,0,0,0] row_mask:0xf bank_mask:0xf
    v_mfma_f32_16x16x32_bf16 v[28:31], v[52:55], v[176:179], v[28:31]
    v_and_b32_dpp v44, v23, v24 quad_perm:[1,1,1,1] row_mask:0xf bank_mask:0xf
    v_and_b32_dpp v45, v23, v25 quad_perm:[1,1,1,1] row_mask:0xf bank_mask:0xf
    v_mfma_f32_16x16x32_bf16 v[32:35], v[52:55], v[180:183], v[32:35]
    v_and_b32_dpp v46, v23, v26 quad_perm:[1,1,1,1] row_mask:0xf bank_mask:0xf
    v_and_b32_dpp v47, v23, v27 quad_perm:[1,1,1,1] row_mask:0xf bank_mask:0xf
    s_cbranch_scc0 L_v
    s_nop 4
    v_permlane32_swap_b32 v32, v36
    v_permlane32_swap_b32 v33, v37
    v_permlane32_swap_b32 v34, v38
    v_permlane32_swap_b32 v35, v39
    s_mov_b32 exec_hi, 0
    v_pk_add_f32 v[28:29], v[28:29], v[36:37]
    v_pk_add_f32 v[30:31], v[30:31], v[38:39]
    v_pk_mul_f32 v[28:29], v[28:29], v[4:5] op_sel_hi:[1,0]
    v_pk_mul_f32 v[30:31], v[30:31], v[4:5] op_sel_hi:[1,0]
    v_cvt_pk_bf16_f32 v28, v28, v29
    v_cvt_pk_bf16_f32 v29, v30, v31
    global_store_dwordx2 v8, v[28:29], s[10:11]
L_end:
    s_endpgm
.section .rodata,"a"
.p2align 6
.amdhsa_kernel standalone__mha_softmax__decode_kernel
  .amdhsa_next_free_vgpr 184
  .amdhsa_next_free_sgpr 72
  .amdhsa_accum_offset 184
  .amdhsa_group_segment_fixed_size 0
  .amdhsa_kernarg_size 48
  .amdhsa_user_sgpr_count 2
  .amdhsa_user_sgpr_kernarg_segment_ptr 1
  .amdhsa_system_sgpr_workgroup_id_x 1
.end_amdhsa_kernel
```
